```python
import torch

def _softmax(x, axis=-1):
    return torch.softmax(x, dim=axis)
def _gelu(x):
    return torch.nn.functional.gelu(x, approximate="tanh")
def _silu(x):
    return torch.nn.functional.silu(x)
def _sigmoid(x):
    return torch.sigmoid(x)
def _layernorm(x, axis=-1, eps=1e-5):
    m = x.mean(dim=axis, keepdim=True)
    v = x.var(dim=axis, keepdim=True, unbiased=False)
    return (x - m) / torch.sqrt(v + eps)
def _scatter_add(tgt, idx, src, axis=0):
    return tgt.clone().index_add_(axis, idx, src)
def _segment_sum(src, seg, n):
    out = torch.zeros((n,) + src.shape[1:], dtype=src.dtype)
    return out.index_add_(0, seg, src)
def _pad(x, pw):
    flat = tuple(v for pair in reversed(pw) for v in pair)
    return torch.nn.functional.pad(x, flat)

kernel_name = 'standalone__linear_kernel_rfa__prompt'

def setup_inputs():

    _w = (lambda a: (lambda t: t.to(torch.bfloat16) if t.is_floating_point() else t)(torch.as_tensor(a)))
    B, H, Sq, Sk, D, M = 1, 32, 2048, 2048, 192, 8
    return {
        "q": _w((lambda *s: torch.randn(*s, dtype=torch.bfloat16) * 0.05)(B, H, Sq, D)),
        "k": _w((lambda *s: torch.randn(*s, dtype=torch.bfloat16) * 0.4)(B, H, Sk, D)),
        "v": _w((lambda *s: torch.randn(*s, dtype=torch.bfloat16) * 0.4)(B, H, Sk, D)),
        "omega": _w((lambda *s: torch.randn(*s, dtype=torch.bfloat16) * 0.8)(M, D)),
    }

def reference(q, k, v, omega):
    d = q.shape[-1]
    m = omega.shape[0]
    scale = float(d) ** -0.25
    qs = q * scale
    ks = k * scale
    q_proj = torch.einsum("bhsd,md->bhsm", qs, omega)
    k_proj = torch.einsum("bhsd,md->bhsm", ks, omega)
    q_sq = 0.5 * torch.einsum("bhsd,bhsd->bhs", qs, qs)[..., None]
    k_sq = 0.5 * torch.einsum("bhsd,bhsd->bhs", ks, ks)[..., None]
    inv_sqrt_m = float(m) ** -0.5
    phi_q = torch.exp(q_proj - q_sq) * inv_sqrt_m + 1e-6
    phi_k = torch.exp(k_proj - k_sq) * inv_sqrt_m + 1e-6
    kv = torch.einsum("bhsm,bhsd->bhmd", phi_k, v)
    z  = torch.einsum("bhsm->bhm", phi_k)
    num = torch.einsum("bhqm,bhmd->bhqd", phi_q, kv)
    den = torch.einsum("bhqm,bhm->bhq", phi_q, z)[..., None] + 1e-6
    return num / den
```

```asm
; @launch grid=(256,1,1) block=(512,1,1) lds=158272
.amdgcn_target "amdgcn-amd-amdhsa--gfx950"
.text
.globl standalone__linear_kernel_rfa__prompt_kernel
.p2align 8
.type standalone__linear_kernel_rfa__prompt_kernel,@function
standalone__linear_kernel_rfa__prompt_kernel:
    s_cmp_ge_u32 s2, 256
    s_cbranch_scc1 L_end_standalone__linear_kernel_rfa__prompt_kernel
    s_load_dwordx4 s[4:7], s[0:1], 0
    s_load_dwordx4 s[8:11], s[0:1], 16
    s_load_dwordx4 s[12:15], s[0:1], 32
    s_load_dwordx2 s[16:17], s[0:1], 48
    v_and_b32 v1, 63, v0
    v_lshrrev_b32 v9, 6, v0
    s_nop 0
    v_readfirstlane_b32 s18, v9
    s_lshr_b32 s54, s2, 3
    s_and_b32 s55, s2, 7
    s_mov_b32 s60, s2
    s_mul_i32 s48, s18, 12288
    s_mul_i32 s19, s60, 98304
    s_add_u32 s19, s19, s48
    s_add_u32 s49, s19, 6144
    v_lshrrev_b32 v9, 3, v1
    v_and_b32 v10, 7, v1
    v_lshrrev_b32 v11, 4, v1
    v_xor_b32 v2, v10, v11
    v_mul_u32_u24 v9, 384, v9
    v_lshl_add_u32 v2, v2, 4, v9
    v_xor_b32 v3, 64, v2
    v_mul_u32_u24 v9, 384, v10
    v_lshl_add_u32 v4, v11, 4, v9
    v_and_b32 v9, 15, v1
    v_mul_u32_u24 v8, 1536, v11
    v_lshl_add_u32 v5, v9, 4, v8
    v_lshl_add_u32 v6, v9, 3, v8
    v_add_u32 v6, 256, v6
    s_waitcnt lgkmcnt(0)
    s_mov_b32 s24, s6
    s_mov_b32 s25, s7
    s_mov_b32 s26, 0x1800000
    s_mov_b32 s27, 0x20000
    s_setprio 2
    s_cmp_lg_u32 s18, 5
    s_cbranch_scc1 L_afterclear
    s_setprio 3
    s_mov_b32 s44, s14
    s_mov_b32 s45, s15
    s_mov_b32 s46, 0x100
    s_mov_b32 s47, 0x20000
    s_mov_b32 s40, s16
    s_mov_b32 s41, s17
    s_mov_b32 s42, 0x10000000
    s_mov_b32 s43, 0x20000
    s_lshl_b32 s56, s54, 15
    s_lshl_b32 s60, s55, 12
    s_add_u32 s53, s56, s60
    s_lshl_b32 s57, s54, 2
    v_mov_b32 v232, -1
    v_mov_b32 v233, -1
    v_mov_b32 v234, -1
    v_mov_b32 v235, -1
    v_lshlrev_b32 v9, 4, v1
    buffer_store_dwordx4 v[232:235], v9, s[40:43], s53 offen offset:0 sc1
    buffer_store_dwordx4 v[232:235], v9, s[40:43], s53 offen offset:1024 sc1
    buffer_store_dwordx4 v[232:235], v9, s[40:43], s53 offen offset:2048 sc1
    s_mov_b32 exec_hi, 0
    s_mov_b32 exec_lo, 0xffff
    buffer_store_dwordx4 v[232:235], v9, s[40:43], s53 offen offset:3072 sc1
    s_mov_b64 exec, -1
    v_mov_b32 v9, s57
    v_mov_b32 v10, 1
    s_waitcnt vmcnt(0)
    s_mov_b64 exec, 1
    buffer_atomic_add v10, v9, s[44:47], 0 offen sc1
    s_mov_b64 exec, -1
    s_setprio 2
L_afterclear:
    s_add_u32 m0, s48, 0
    s_mov_b32 s32, s10
    s_mov_b32 s33, s11
    buffer_load_dwordx4 v2, s[24:27], s19 offen offset:0 nt lds
    s_add_u32 m0, s48, 896
    s_mov_b32 s34, 0xc00
    s_mov_b32 s35, 0x20000
    buffer_load_dwordx4 v2, s[24:27], s19 offen offset:128 nt lds
    s_add_u32 m0, s48, 1792
    s_mov_b32 s28, s8
    s_mov_b32 s29, s9
    buffer_load_dwordx4 v2, s[24:27], s19 offen offset:256 nt lds
    s_add_u32 m0, s48, 0
    s_mov_b32 s30, 0x1800000
    s_mov_b32 s31, 0x20000
    buffer_load_dwordx4 v3, s[24:27], s19 offen offset:3072 nt lds
    s_add_u32 m0, s48, 896
    s_mov_b32 s44, s14
    buffer_load_dwordx4 v3, s[24:27], s19 offen offset:3200 nt lds
    s_add_u32 m0, s48, 1792
    s_mov_b32 s45, s15
    buffer_load_dwordx4 v3, s[24:27], s19 offen offset:3328 nt lds
    s_add_u32 m0, s48, 6144
    s_mov_b32 s46, 0x100
    buffer_load_dwordx4 v2, s[24:27], s49 offen offset:0 nt lds
    s_add_u32 m0, s48, 7040
    s_mov_b32 s47, 0x20000
    buffer_load_dwordx4 v2, s[24:27], s49 offen offset:128 nt lds
    s_add_u32 m0, s48, 7936
    s_mov_b32 s40, s16
    buffer_load_dwordx4 v2, s[24:27], s49 offen offset:256 nt lds
    s_add_u32 m0, s48, 6144
    s_mov_b32 s41, s17
    buffer_load_dwordx4 v3, s[24:27], s49 offen offset:3072 nt lds
    s_add_u32 m0, s48, 7040
    s_mov_b32 s42, 0x10000000
    buffer_load_dwordx4 v3, s[24:27], s49 offen offset:3200 nt lds
    s_add_u32 m0, s48, 7936
    s_mov_b32 s43, 0x20000
    buffer_load_dwordx4 v3, s[24:27], s49 offen offset:3328 nt lds
    buffer_load_dwordx4 v[16:19], v4, s[32:35], 0 offen offset:0
    buffer_load_dwordx4 v[20:23], v4, s[32:35], 0 offen offset:64
    buffer_load_dwordx4 v[24:27], v4, s[32:35], 0 offen offset:128
    buffer_load_dwordx4 v[28:31], v4, s[32:35], 0 offen offset:192
    buffer_load_dwordx4 v[32:35], v4, s[32:35], 0 offen offset:256
    buffer_load_dwordx4 v[36:39], v4, s[32:35], 0 offen offset:320
    buffer_load_dwordx4 v[40:43], v5, s[28:31], s19 offen offset:0 nt
    buffer_load_dwordx2 v[72:73], v6, s[28:31], s19 offen offset:0 nt
    buffer_load_dwordx4 v[44:47], v5, s[28:31], s19 offen offset:384 nt
    buffer_load_dwordx2 v[74:75], v6, s[28:31], s19 offen offset:384 nt
    buffer_load_dwordx4 v[48:51], v5, s[28:31], s19 offen offset:768 nt
    buffer_load_dwordx2 v[76:77], v6, s[28:31], s19 offen offset:768 nt
    buffer_load_dwordx4 v[52:55], v5, s[28:31], s19 offen offset:1152 nt
    buffer_load_dwordx2 v[78:79], v6, s[28:31], s19 offen offset:1152 nt
    buffer_load_dwordx4 v[56:59], v5, s[28:31], s49 offen offset:0 nt
    buffer_load_dwordx2 v[80:81], v6, s[28:31], s49 offen offset:0 nt
    buffer_load_dwordx4 v[60:63], v5, s[28:31], s49 offen offset:384 nt
    buffer_load_dwordx2 v[82:83], v6, s[28:31], s49 offen offset:384 nt
    buffer_load_dwordx4 v[64:67], v5, s[28:31], s49 offen offset:768 nt
    buffer_load_dwordx2 v[84:85], v6, s[28:31], s49 offen offset:768 nt
    buffer_load_dwordx4 v[68:71], v5, s[28:31], s49 offen offset:1152 nt
    buffer_load_dwordx2 v[86:87], v6, s[28:31], s49 offen offset:1152 nt
    s_lshl_b32 s56, s54, 15
    s_lshl_b32 s60, s55, 12
    s_add_u32 s53, s56, s60
    s_lshl_b32 s57, s54, 2
    s_cmp_lg_u32 s18, 7
    s_cbranch_scc1 L_nocnt
    v_mov_b32 v9, s57
    buffer_load_dword v15, v9, s[44:47], 0 offen sc1
L_nocnt:
    s_setprio 0
    s_mov_b32 s20, s4
    s_mov_b32 s21, s5
    s_mov_b32 s22, 0x1800000
    s_mov_b32 s23, 0x20000
    s_mov_b32 s36, s12
    s_mov_b32 s37, s13
    s_mov_b32 s38, 0x1800000
    s_mov_b32 s39, 0x20000
    v_and_b32 v9, 15, v1
    v_lshrrev_b32 v11, 4, v1
    v_lshrrev_b32 v10, 1, v9
    v_xor_b32 v10, v10, v11
    v_lshlrev_b32 v10, 4, v10
    v_and_b32 v7, 7, v1
    v_lshl_add_u32 v10, v7, 7, v10
    v_lshrrev_b32 v9, 3, v9
    v_mul_u32_u24 v9, 3072, v9
    v_add3_u32 v7, v9, v10, s48
    v_xor_b32 v8, 64, v7
    v_mov_b32 v12, 0xbd553b95
    v_mov_b32 v13, 0x358637bd
    s_mov_b32 s50, 0x3ec66f78
    s_mov_b32 s51, 0x05040100
    s_mov_b32 s52, 0x07060302
    v_mov_b32 v9, 158208
    v_mov_b32 v10, 0
    s_cmp_lg_u32 s18, 0
    s_cbranch_scc1 L_noinit
    ds_write_b32 v9, v10
L_noinit:
    s_waitcnt vmcnt(16) lgkmcnt(0)
    ds_read_b128 v[88:91], v7 offset:0
    ds_read_b128 v[92:95], v8 offset:0
    ds_read_b128 v[96:99], v7 offset:1024
    ds_read_b128 v[100:103], v8 offset:1024
    ds_read_b128 v[104:107], v7 offset:2048
    ds_read_b128 v[108:111], v8 offset:2048
    ds_read_b128 v[112:115], v7 offset:6144
    ds_read_b128 v[116:119], v8 offset:6144
    ds_read_b128 v[120:123], v7 offset:7168
    ds_read_b128 v[124:127], v8 offset:7168
    ds_read_b128 v[128:131], v7 offset:8192
    ds_read_b128 v[132:135], v8 offset:8192
    s_waitcnt lgkmcnt(6)
    v_mfma_f32_16x16x32_bf16 v[136:139], v[88:91], v[16:19], 0
    v_dot2_f32_bf16 v228, v88, v88, 0
    v_dot2_f32_bf16 v229, v89, v89, 0
    v_dot2_f32_bf16 v230, v90, v90, 0
    v_dot2_f32_bf16 v231, v91, v91, 0
    v_mfma_f32_16x16x32_bf16 v[136:139], v[92:95], v[20:23], v[136:139]
    v_dot2c_f32_bf16 v228, v92, v92
    v_dot2c_f32_bf16 v229, v93, v93
    v_dot2c_f32_bf16 v230, v94, v94
    v_dot2c_f32_bf16 v231, v95, v95
    v_mfma_f32_16x16x32_bf16 v[136:139], v[96:99], v[24:27], v[136:139]
    v_dot2c_f32_bf16 v228, v96, v96
    v_dot2c_f32_bf16 v229, v97, v97
    v_dot2c_f32_bf16 v230, v98, v98
    v_dot2c_f32_bf16 v231, v99, v99
    v_mfma_f32_16x16x32_bf16 v[136:139], v[100:103], v[28:31], v[136:139]
    v_dot2c_f32_bf16 v228, v100, v100
    v_dot2c_f32_bf16 v229, v101, v101
    v_dot2c_f32_bf16 v230, v102, v102
    v_dot2c_f32_bf16 v231, v103, v103
    v_mfma_f32_16x16x32_bf16 v[136:139], v[104:107], v[32:35], v[136:139]
    v_dot2c_f32_bf16 v228, v104, v104
    v_dot2c_f32_bf16 v229, v105, v105
    v_dot2c_f32_bf16 v230, v106, v106
    v_dot2c_f32_bf16 v231, v107, v107
    v_mfma_f32_16x16x32_bf16 v[136:139], v[108:111], v[36:39], v[136:139]
    v_dot2c_f32_bf16 v228, v108, v108
    v_dot2c_f32_bf16 v229, v109, v109
    v_dot2c_f32_bf16 v230, v110, v110
    v_dot2c_f32_bf16 v231, v111, v111
    s_nop 0
    v_add_f32 v228, v228, v229
    s_nop 0
    v_add_f32 v230, v230, v231
    v_add_f32 v228, v228, v230
    s_nop 1
    v_mfma_f32_16x16x4_f32 v[140:143], v228, v12, 0
    s_waitcnt lgkmcnt(0)
    v_mfma_f32_16x16x32_bf16 v[144:147], v[112:115], v[16:19], 0
    v_dot2_f32_bf16 v228, v112, v112, 0
    v_dot2_f32_bf16 v229, v113, v113, 0
    v_dot2_f32_bf16 v230, v114, v114, 0
    v_dot2_f32_bf16 v231, v115, v115, 0
    v_mfma_f32_16x16x32_bf16 v[144:147], v[116:119], v[20:23], v[144:147]
    v_dot2c_f32_bf16 v228, v116, v116
    v_dot2c_f32_bf16 v229, v117, v117
    v_dot2c_f32_bf16 v230, v118, v118
    v_dot2c_f32_bf16 v231, v119, v119
    v_mfma_f32_16x16x32_bf16 v[144:147], v[120:123], v[24:27], v[144:147]
    v_dot2c_f32_bf16 v228, v120, v120
    v_dot2c_f32_bf16 v229, v121, v121
    v_dot2c_f32_bf16 v230, v122, v122
    v_dot2c_f32_bf16 v231, v123, v123
    v_mfma_f32_16x16x32_bf16 v[144:147], v[124:127], v[28:31], v[144:147]
    v_dot2c_f32_bf16 v228, v124, v124
    v_dot2c_f32_bf16 v229, v125, v125
    v_dot2c_f32_bf16 v230, v126, v126
    v_dot2c_f32_bf16 v231, v127, v127
    v_mfma_f32_16x16x32_bf16 v[144:147], v[128:131], v[32:35], v[144:147]
    v_dot2c_f32_bf16 v228, v128, v128
    v_dot2c_f32_bf16 v229, v129, v129
    v_dot2c_f32_bf16 v230, v130, v130
    v_dot2c_f32_bf16 v231, v131, v131
    v_mfma_f32_16x16x32_bf16 v[144:147], v[132:135], v[36:39], v[144:147]
    v_dot2c_f32_bf16 v228, v132, v132
    v_dot2c_f32_bf16 v229, v133, v133
    v_dot2c_f32_bf16 v230, v134, v134
    v_dot2c_f32_bf16 v231, v135, v135
    s_nop 0
    v_add_f32 v228, v228, v229
    s_nop 0
    v_add_f32 v230, v230, v231
    v_add_f32 v228, v228, v230
    s_nop 1
    v_mfma_f32_16x16x4_f32 v[148:151], v228, v12, 0
    v_fma_f32 v136, v136, s50, v140
    v_fma_f32 v137, v137, s50, v141
    v_fma_f32 v138, v138, s50, v142
    v_fma_f32 v139, v139, s50, v143
    v_exp_f32 v136, v136
    v_exp_f32 v137, v137
    v_exp_f32 v138, v138
    v_exp_f32 v139, v139
    v_fmamk_f32 v136, v136, 0x3eb504f3, v13
    v_fmamk_f32 v137, v137, 0x3eb504f3, v13
    v_fmamk_f32 v138, v138, 0x3eb504f3, v13
    v_fmamk_f32 v139, v139, 0x3eb504f3, v13
    v_cvt_pk_bf16_f32 v152, v136, v137
    v_cvt_pk_bf16_f32 v153, v138, v139
    v_fma_f32 v144, v144, s50, v148
    v_fma_f32 v145, v145, s50, v149
    v_fma_f32 v146, v146, s50, v150
    v_fma_f32 v147, v147, s50, v151
    v_exp_f32 v144, v144
    v_exp_f32 v145, v145
    v_exp_f32 v146, v146
    v_exp_f32 v147, v147
    v_fmamk_f32 v144, v144, 0x3eb504f3, v13
    v_fmamk_f32 v145, v145, 0x3eb504f3, v13
    v_fmamk_f32 v146, v146, 0x3eb504f3, v13
    v_fmamk_f32 v147, v147, 0x3eb504f3, v13
    v_cvt_pk_bf16_f32 v154, v144, v145
    v_cvt_pk_bf16_f32 v155, v146, v147
    v_mov_b32 v224, 0x3f803f80
    v_mov_b32 v225, 0x3f803f80
    v_mov_b32 v226, 0x3f803f80
    v_mov_b32 v227, 0x3f803f80
    s_waitcnt vmcnt(12)
    v_perm_b32 v88, v44, v40, s51
    v_perm_b32 v92, v44, v40, s52
    v_perm_b32 v96, v45, v41, s51
    v_perm_b32 v100, v45, v41, s52
    v_perm_b32 v104, v46, v42, s51
    v_perm_b32 v108, v46, v42, s52
    v_perm_b32 v112, v47, v43, s51
    v_perm_b32 v116, v47, v43, s52
    v_perm_b32 v120, v74, v72, s51
    v_perm_b32 v124, v74, v72, s52
    v_perm_b32 v128, v75, v73, s51
    v_perm_b32 v132, v75, v73, s52
    v_mfma_f32_16x16x32_bf16 v[208:211], v[152:155], v[224:227], 0
    s_waitcnt vmcnt(8)
    v_perm_b32 v89, v52, v48, s51
    v_perm_b32 v93, v52, v48, s52
    v_perm_b32 v97, v53, v49, s51
    v_perm_b32 v101, v53, v49, s52
    v_perm_b32 v105, v54, v50, s51
    v_perm_b32 v109, v54, v50, s52
    v_perm_b32 v113, v55, v51, s51
    v_perm_b32 v117, v55, v51, s52
    v_perm_b32 v121, v78, v76, s51
    v_perm_b32 v125, v78, v76, s52
    v_perm_b32 v129, v79, v77, s51
    v_perm_b32 v133, v79, v77, s52
    s_waitcnt vmcnt(4)
    v_perm_b32 v90, v60, v56, s51
    v_perm_b32 v94, v60, v56, s52
    v_perm_b32 v98, v61, v57, s51
    v_perm_b32 v102, v61, v57, s52
    v_perm_b32 v106, v62, v58, s51
    v_perm_b32 v110, v62, v58, s52
    v_perm_b32 v114, v63, v59, s51
    v_perm_b32 v118, v63, v59, s52
    v_perm_b32 v122, v82, v80, s51
    v_perm_b32 v126, v82, v80, s52
    v_perm_b32 v130, v83, v81, s51
    v_perm_b32 v134, v83, v81, s52
    s_waitcnt vmcnt(0)
    v_perm_b32 v91, v68, v64, s51
    v_perm_b32 v95, v68, v64, s52
    v_perm_b32 v99, v69, v65, s51
    v_perm_b32 v103, v69, v65, s52
    v_perm_b32 v107, v70, v66, s51
    v_perm_b32 v111, v70, v66, s52
    v_perm_b32 v115, v71, v67, s51
    v_perm_b32 v119, v71, v67, s52
    v_perm_b32 v123, v86, v84, s51
    v_perm_b32 v127, v86, v84, s52
    v_perm_b32 v131, v87, v85, s51
    v_perm_b32 v135, v87, v85, s52
    s_mul_i32 s60, s18, 6656
    s_add_u32 s60, s60, 98304
    v_lshl_add_u32 v9, v1, 4, s60
    v_mfma_f32_16x16x32_bf16 v[160:163], v[152:155], v[88:91], 0
    v_mfma_f32_16x16x32_bf16 v[164:167], v[152:155], v[92:95], 0
    v_mfma_f32_16x16x32_bf16 v[168:171], v[152:155], v[96:99], 0
    v_mfma_f32_16x16x32_bf16 v[172:175], v[152:155], v[100:103], 0
    v_mfma_f32_16x16x32_bf16 v[176:179], v[152:155], v[104:107], 0
    v_mfma_f32_16x16x32_bf16 v[180:183], v[152:155], v[108:111], 0
    v_mfma_f32_16x16x32_bf16 v[184:187], v[152:155], v[112:115], 0
    v_mfma_f32_16x16x32_bf16 v[188:191], v[152:155], v[116:119], 0
    v_mfma_f32_16x16x32_bf16 v[192:195], v[152:155], v[120:123], 0
    v_mfma_f32_16x16x32_bf16 v[196:199], v[152:155], v[124:127], 0
    v_mfma_f32_16x16x32_bf16 v[200:203], v[152:155], v[128:131], 0
    v_mfma_f32_16x16x32_bf16 v[204:207], v[152:155], v[132:135], 0
    s_mov_b32 exec_hi, 0
    ds_write_b128 v9, v[208:211] offset:6144
    ds_write_b128 v9, v[160:163] offset:0
    ds_write_b128 v9, v[164:167] offset:512
    ds_write_b128 v9, v[168:171] offset:1024
    ds_write_b128 v9, v[172:175] offset:1536
    ds_write_b128 v9, v[176:179] offset:2048
    ds_write_b128 v9, v[180:183] offset:2560
    ds_write_b128 v9, v[184:187] offset:3072
    ds_write_b128 v9, v[188:191] offset:3584
    ds_write_b128 v9, v[192:195] offset:4096
    ds_write_b128 v9, v[196:199] offset:4608
    ds_write_b128 v9, v[200:203] offset:5120
    ds_write_b128 v9, v[204:207] offset:5632
    s_mov_b32 exec_hi, -1
    s_cmp_lg_u32 s18, 7
    s_cbranch_scc1 L_cntok
    s_mov_b32 s62, 0
L_cntloop:
    v_readfirstlane_b32 s60, v15
    s_nop 1
    s_cmp_ge_u32 s60, 8
    s_cbranch_scc1 L_cntok
    s_add_u32 s62, s62, 1
    s_cmp_ge_u32 s62, 20000
    s_cbranch_scc1 L_cntok
    s_sleep 4
    v_mov_b32 v9, s57
    buffer_load_dword v15, v9, s[44:47], 0 offen sc1
    s_waitcnt vmcnt(0)
    s_branch L_cntloop
L_cntok:
    s_cmp_ge_u32 s18, 4
    s_cbranch_scc1 L_hi1
    s_add_u32 m0, s48, 0
    s_nop 0
    buffer_load_dwordx4 v2, s[20:23], s19 offen offset:0 nt lds
    s_add_u32 m0, s48, 896
    s_nop 0
    buffer_load_dwordx4 v2, s[20:23], s19 offen offset:128 nt lds
    s_add_u32 m0, s48, 1792
    s_nop 0
    buffer_load_dwordx4 v2, s[20:23], s19 offen offset:256 nt lds
    s_add_u32 m0, s48, 0
    s_nop 0
    buffer_load_dwordx4 v3, s[20:23], s19 offen offset:3072 nt lds
    s_add_u32 m0, s48, 896
    s_nop 0
    buffer_load_dwordx4 v3, s[20:23], s19 offen offset:3200 nt lds
    s_add_u32 m0, s48, 1792
    s_nop 0
    buffer_load_dwordx4 v3, s[20:23], s19 offen offset:3328 nt lds
    s_add_u32 m0, s48, 6144
    s_nop 0
    buffer_load_dwordx4 v2, s[20:23], s49 offen offset:0 nt lds
    s_add_u32 m0, s48, 7040
    s_nop 0
    buffer_load_dwordx4 v2, s[20:23], s49 offen offset:128 nt lds
    s_add_u32 m0, s48, 7936
    s_nop 0
    buffer_load_dwordx4 v2, s[20:23], s49 offen offset:256 nt lds
    s_add_u32 m0, s48, 6144
    s_nop 0
    buffer_load_dwordx4 v3, s[20:23], s49 offen offset:3072 nt lds
    s_add_u32 m0, s48, 7040
    s_nop 0
    buffer_load_dwordx4 v3, s[20:23], s49 offen offset:3200 nt lds
    s_add_u32 m0, s48, 7936
    s_nop 0
    buffer_load_dwordx4 v3, s[20:23], s49 offen offset:3328 nt lds
    s_mul_i32 s60, s18, 104
    v_add_u32 v14, s60, v1
    v_lshlrev_b32 v11, 4, v14
    v_add_u32 v11, 98304, v11
    s_mul_i32 s60, s18, 832
    v_lshl_add_u32 v10, v1, 4, s60
    s_add_u32 s60, s55, 1
    s_and_b32 s60, s60, 7
    s_lshl_b32 s60, s60, 12
    s_add_u32 s94, s60, s56
    s_add_u32 s60, s55, 2
    s_and_b32 s60, s60, 7
    s_lshl_b32 s60, s60, 12
    s_add_u32 s95, s60, s56
    s_add_u32 s60, s55, 3
    s_and_b32 s60, s60, 7
    s_lshl_b32 s60, s60, 12
    s_add_u32 s96, s60, s56
    s_add_u32 s60, s55, 4
    s_and_b32 s60, s60, 7
    s_lshl_b32 s60, s60, 12
    s_add_u32 s97, s60, s56
    s_add_u32 s60, s55, 5
    s_and_b32 s60, s60, 7
    s_lshl_b32 s60, s60, 12
    s_add_u32 s98, s60, s56
    s_add_u32 s60, s55, 6
    s_and_b32 s60, s60, 7
    s_lshl_b32 s60, s60, 12
    s_add_u32 s99, s60, s56
    s_add_u32 s60, s55, 7
    s_and_b32 s60, s60, 7
    s_lshl_b32 s60, s60, 12
    s_add_u32 s100, s60, s56
    s_waitcnt lgkmcnt(0)
    s_barrier
    s_setprio 3
    s_mov_b32 exec_hi, 0xfffff
    ds_read_b128 v[160:163], v11 offset:0
    ds_read_b128 v[164:167], v11 offset:6656
    ds_read_b128 v[168:171], v11 offset:13312
    ds_read_b128 v[172:175], v11 offset:19968
    ds_read_b128 v[176:179], v11 offset:26624
    ds_read_b128 v[180:183], v11 offset:33280
    ds_read_b128 v[184:187], v11 offset:39936
    ds_read_b128 v[188:191], v11 offset:46592
    ds_read_b128 v[40:43], v11 offset:832
    ds_read_b128 v[44:47], v11 offset:7488
    ds_read_b128 v[48:51], v11 offset:14144
    ds_read_b128 v[52:55], v11 offset:20800
    ds_read_b128 v[56:59], v11 offset:27456
    ds_read_b128 v[60:63], v11 offset:34112
    ds_read_b128 v[64:67], v11 offset:40768
    s_waitcnt lgkmcnt(7)
    ds_read_b128 v[68:71], v11 offset:47424
    v_pk_add_f32 v[160:161], v[160:161], v[164:165]
    v_pk_add_f32 v[162:163], v[162:163], v[166:167]
    v_pk_add_f32 v[168:169], v[168:169], v[172:173]
    v_pk_add_f32 v[170:171], v[170:171], v[174:175]
    v_pk_add_f32 v[176:177], v[176:177], v[180:181]
    v_pk_add_f32 v[178:179], v[178:179], v[182:183]
    v_pk_add_f32 v[184:185], v[184:185], v[188:189]
    v_pk_add_f32 v[186:187], v[186:187], v[190:191]
    v_pk_add_f32 v[160:161], v[160:161], v[168:169]
    v_pk_add_f32 v[162:163], v[162:163], v[170:171]
    v_pk_add_f32 v[176:177], v[176:177], v[184:185]
    v_pk_add_f32 v[178:179], v[178:179], v[186:187]
    v_pk_add_f32 v[232:233], v[160:161], v[176:177]
    v_pk_add_f32 v[234:235], v[162:163], v[178:179]
    v_cvt_pk_bf16_f32 v212, v232, v233
    v_cvt_pk_bf16_f32 v213, v234, v235
    s_waitcnt lgkmcnt(0)
    v_pk_add_f32 v[40:41], v[40:41], v[44:45]
    v_pk_add_f32 v[42:43], v[42:43], v[46:47]
    v_pk_add_f32 v[48:49], v[48:49], v[52:53]
    v_pk_add_f32 v[50:51], v[50:51], v[54:55]
    v_pk_add_f32 v[56:57], v[56:57], v[60:61]
    v_pk_add_f32 v[58:59], v[58:59], v[62:63]
    v_pk_add_f32 v[64:65], v[64:65], v[68:69]
    v_pk_add_f32 v[66:67], v[66:67], v[70:71]
    v_pk_add_f32 v[40:41], v[40:41], v[48:49]
    v_pk_add_f32 v[42:43], v[42:43], v[50:51]
    v_pk_add_f32 v[56:57], v[56:57], v[64:65]
    v_pk_add_f32 v[58:59], v[58:59], v[66:67]
    v_pk_add_f32 v[236:237], v[40:41], v[56:57]
    v_pk_add_f32 v[238:239], v[42:43], v[58:59]
    v_cvt_pk_bf16_f32 v214, v236, v237
    v_cvt_pk_bf16_f32 v215, v238, v239
    v_min_u32 v212, 0xfffffffe, v212
    v_min_u32 v213, 0xfffffffe, v213
    v_min_u32 v214, 0xfffffffe, v214
    v_min_u32 v215, 0xfffffffe, v215
    buffer_store_dwordx4 v[212:215], v10, s[40:43], s53 offen sc1
    s_setprio 0
    s_mov_b32 exec_hi, -1
    s_waitcnt vmcnt(1)
L_feat:
    ds_read_b128 v[88:91], v7 offset:0
    ds_read_b128 v[92:95], v8 offset:0
    ds_read_b128 v[96:99], v7 offset:1024
    ds_read_b128 v[100:103], v8 offset:1024
    ds_read_b128 v[104:107], v7 offset:2048
    ds_read_b128 v[108:111], v8 offset:2048
    ds_read_b128 v[112:115], v7 offset:6144
    ds_read_b128 v[116:119], v8 offset:6144
    ds_read_b128 v[120:123], v7 offset:7168
    ds_read_b128 v[124:127], v8 offset:7168
    ds_read_b128 v[128:131], v7 offset:8192
    ds_read_b128 v[132:135], v8 offset:8192
    s_waitcnt lgkmcnt(6)
    v_mfma_f32_16x16x32_bf16 v[136:139], v[16:19], v[88:91], 0
    v_dot2_f32_bf16 v228, v88, v88, 0
    v_dot2_f32_bf16 v229, v89, v89, 0
    v_dot2_f32_bf16 v230, v90, v90, 0
    v_dot2_f32_bf16 v231, v91, v91, 0
    v_mfma_f32_16x16x32_bf16 v[136:139], v[20:23], v[92:95], v[136:139]
    v_dot2c_f32_bf16 v228, v92, v92
    v_dot2c_f32_bf16 v229, v93, v93
    v_dot2c_f32_bf16 v230, v94, v94
    v_dot2c_f32_bf16 v231, v95, v95
    v_mfma_f32_16x16x32_bf16 v[136:139], v[24:27], v[96:99], v[136:139]
    v_dot2c_f32_bf16 v228, v96, v96
    v_dot2c_f32_bf16 v229, v97, v97
    v_dot2c_f32_bf16 v230, v98, v98
    v_dot2c_f32_bf16 v231, v99, v99
    v_mfma_f32_16x16x32_bf16 v[136:139], v[28:31], v[100:103], v[136:139]
    v_dot2c_f32_bf16 v228, v100, v100
    v_dot2c_f32_bf16 v229, v101, v101
    v_dot2c_f32_bf16 v230, v102, v102
    v_dot2c_f32_bf16 v231, v103, v103
    v_mfma_f32_16x16x32_bf16 v[136:139], v[32:35], v[104:107], v[136:139]
    v_dot2c_f32_bf16 v228, v104, v104
    v_dot2c_f32_bf16 v229, v105, v105
    v_dot2c_f32_bf16 v230, v106, v106
    v_dot2c_f32_bf16 v231, v107, v107
    v_mfma_f32_16x16x32_bf16 v[136:139], v[36:39], v[108:111], v[136:139]
    v_dot2c_f32_bf16 v228, v108, v108
    v_dot2c_f32_bf16 v229, v109, v109
    v_dot2c_f32_bf16 v230, v110, v110
    v_dot2c_f32_bf16 v231, v111, v111
    s_nop 0
    v_add_f32 v228, v228, v229
    s_nop 0
    v_add_f32 v230, v230, v231
    v_add_f32 v228, v228, v230
    s_nop 1
    v_mfma_f32_16x16x4_f32 v[140:143], v12, v228, 0
    s_waitcnt lgkmcnt(0)
    v_mfma_f32_16x16x32_bf16 v[144:147], v[16:19], v[112:115], 0
    v_dot2_f32_bf16 v228, v112, v112, 0
    v_dot2_f32_bf16 v229, v113, v113, 0
    v_dot2_f32_bf16 v230, v114, v114, 0
    v_dot2_f32_bf16 v231, v115, v115, 0
    v_mfma_f32_16x16x32_bf16 v[144:147], v[20:23], v[116:119], v[144:147]
    v_dot2c_f32_bf16 v228, v116, v116
    v_dot2c_f32_bf16 v229, v117, v117
    v_dot2c_f32_bf16 v230, v118, v118
    v_dot2c_f32_bf16 v231, v119, v119
    v_mfma_f32_16x16x32_bf16 v[144:147], v[24:27], v[120:123], v[144:147]
    v_dot2c_f32_bf16 v228, v120, v120
    v_dot2c_f32_bf16 v229, v121, v121
    v_dot2c_f32_bf16 v230, v122, v122
    v_dot2c_f32_bf16 v231, v123, v123
    v_mfma_f32_16x16x32_bf16 v[144:147], v[28:31], v[124:127], v[144:147]
    v_dot2c_f32_bf16 v228, v124, v124
    v_dot2c_f32_bf16 v229, v125, v125
    v_dot2c_f32_bf16 v230, v126, v126
    v_dot2c_f32_bf16 v231, v127, v127
    v_mfma_f32_16x16x32_bf16 v[144:147], v[32:35], v[128:131], v[144:147]
    v_dot2c_f32_bf16 v228, v128, v128
    v_dot2c_f32_bf16 v229, v129, v129
    v_dot2c_f32_bf16 v230, v130, v130
    v_dot2c_f32_bf16 v231, v131, v131
    v_mfma_f32_16x16x32_bf16 v[144:147], v[36:39], v[132:135], v[144:147]
    v_dot2c_f32_bf16 v228, v132, v132
    v_dot2c_f32_bf16 v229, v133, v133
    v_dot2c_f32_bf16 v230, v134, v134
    v_dot2c_f32_bf16 v231, v135, v135
    s_nop 0
    v_add_f32 v228, v228, v229
    s_nop 0
    v_add_f32 v230, v230, v231
    v_add_f32 v228, v228, v230
    s_nop 1
    v_mfma_f32_16x16x4_f32 v[148:151], v12, v228, 0
    v_fma_f32 v136, v136, s50, v140
    v_fma_f32 v137, v137, s50, v141
    v_fma_f32 v138, v138, s50, v142
    v_fma_f32 v139, v139, s50, v143
    v_exp_f32 v136, v136
    v_exp_f32 v137, v137
    v_exp_f32 v138, v138
    v_exp_f32 v139, v139
    v_fmamk_f32 v136, v136, 0x3eb504f3, v13
    v_fmamk_f32 v137, v137, 0x3eb504f3, v13
    v_fmamk_f32 v138, v138, 0x3eb504f3, v13
    v_fmamk_f32 v139, v139, 0x3eb504f3, v13
    v_cvt_pk_bf16_f32 v152, v136, v137
    v_cvt_pk_bf16_f32 v153, v138, v139
    v_fma_f32 v144, v144, s50, v148
    v_fma_f32 v145, v145, s50, v149
    v_fma_f32 v146, v146, s50, v150
    v_fma_f32 v147, v147, s50, v151
    v_exp_f32 v144, v144
    v_exp_f32 v145, v145
    v_exp_f32 v146, v146
    v_exp_f32 v147, v147
    v_fmamk_f32 v144, v144, 0x3eb504f3, v13
    v_fmamk_f32 v145, v145, 0x3eb504f3, v13
    v_fmamk_f32 v146, v146, 0x3eb504f3, v13
    v_fmamk_f32 v147, v147, 0x3eb504f3, v13
    v_cvt_pk_bf16_f32 v154, v144, v145
    v_cvt_pk_bf16_f32 v155, v146, v147
    s_cmp_ge_u32 s18, 4
    s_cbranch_scc1 L_join0
    v_mov_b32 v9, 158208
L_trig:
    ds_read_b32 v11, v9
    s_waitcnt lgkmcnt(0)
    v_readfirstlane_b32 s60, v11
    s_nop 1
    s_cmp_lg_u32 s60, 0
    s_cbranch_scc1 L_trigok
    s_sleep 1
    s_branch L_trig
L_trigok:
    s_mov_b32 exec_hi, 0xfffff
    s_setprio 3
    buffer_load_dwordx4 v[40:43], v10, s[40:43], s94 offen sc1
    buffer_load_dwordx4 v[44:47], v10, s[40:43], s95 offen sc1
    buffer_load_dwordx4 v[48:51], v10, s[40:43], s96 offen sc1
    buffer_load_dwordx4 v[52:55], v10, s[40:43], s97 offen sc1
    buffer_load_dwordx4 v[56:59], v10, s[40:43], s98 offen sc1
    buffer_load_dwordx4 v[60:63], v10, s[40:43], s99 offen sc1
    buffer_load_dwordx4 v[64:67], v10, s[40:43], s100 offen sc1
    v_lshlrev_b32 v232, 16, v212
    v_and_b32 v233, 0xffff0000, v212
    v_lshlrev_b32 v234, 16, v213
    v_and_b32 v235, 0xffff0000, v213
    v_lshlrev_b32 v236, 16, v214
    v_and_b32 v237, 0xffff0000, v214
    v_lshlrev_b32 v238, 16, v215
    v_and_b32 v239, 0xffff0000, v215
    v_add_u32 v9, 0, v14
    v_and_b32 v184, 31, v9
    v_lshrrev_b32 v9, 5, v9
    v_lshlrev_b32 v184, 3, v184
    v_lshl_add_u32 v9, v9, 9, v184
    v_add_u32 v9, 151552, v9
    v_add_u32 v11, 52, v14
    v_and_b32 v184, 31, v11
    v_lshrrev_b32 v11, 5, v11
    v_lshlrev_b32 v184, 3, v184
    v_lshl_add_u32 v11, v11, 9, v184
    v_add_u32 v11, 151552, v11
    s_mov_b32 s92, 0x00003f80
    s_mov_b32 s93, 0x3f800000
    s_mov_b32 s62, 0
L_poll:
    s_waitcnt vmcnt(0)
    v_max3_u32 v180, v40, v41, v42
    v_max3_u32 v181, v43, v44, v45
    v_max3_u32 v180, v180, v46, v47
    v_max3_u32 v181, v181, v48, v49
    v_max3_u32 v180, v180, v50, v51
    v_max3_u32 v181, v181, v52, v53
    v_max3_u32 v180, v180, v54, v55
    v_max3_u32 v181, v181, v56, v57
    v_max3_u32 v180, v180, v58, v59
    v_max3_u32 v181, v181, v60, v61
    v_max3_u32 v180, v180, v62, v63
    v_max3_u32 v181, v181, v64, v65
    v_max3_u32 v180, v180, v66, v67
    v_max_u32 v180, v180, v181
    v_cmp_eq_u32 vcc, -1, v180
    s_cbranch_vccz L_ready
    s_add_u32 s62, s62, 1
    s_cmp_ge_u32 s62, 20000
    s_cbranch_scc1 L_ready
    s_sleep 2
    v_max3_u32 v180, v40, v41, v42
    v_max_u32 v180, v180, v43
    v_cmp_eq_u32 vcc, -1, v180
    s_cbranch_vccz L_skip0
    buffer_load_dwordx4 v[40:43], v10, s[40:43], s94 offen sc1
L_skip0:
    v_max3_u32 v180, v44, v45, v46
    v_max_u32 v180, v180, v47
    v_cmp_eq_u32 vcc, -1, v180
    s_cbranch_vccz L_skip1
    buffer_load_dwordx4 v[44:47], v10, s[40:43], s95 offen sc1
L_skip1:
    v_max3_u32 v180, v48, v49, v50
    v_max_u32 v180, v180, v51
    v_cmp_eq_u32 vcc, -1, v180
    s_cbranch_vccz L_skip2
    buffer_load_dwordx4 v[48:51], v10, s[40:43], s96 offen sc1
L_skip2:
    v_max3_u32 v180, v52, v53, v54
    v_max_u32 v180, v180, v55
    v_cmp_eq_u32 vcc, -1, v180
    s_cbranch_vccz L_skip3
    buffer_load_dwordx4 v[52:55], v10, s[40:43], s97 offen sc1
L_skip3:
    v_max3_u32 v180, v56, v57, v58
    v_max_u32 v180, v180, v59
    v_cmp_eq_u32 vcc, -1, v180
    s_cbranch_vccz L_skip4
    buffer_load_dwordx4 v[56:59], v10, s[40:43], s98 offen sc1
L_skip4:
    v_max3_u32 v180, v60, v61, v62
    v_max_u32 v180, v180, v63
    v_cmp_eq_u32 vcc, -1, v180
    s_cbranch_vccz L_skip5
    buffer_load_dwordx4 v[60:63], v10, s[40:43], s99 offen sc1
L_skip5:
    v_max3_u32 v180, v64, v65, v66
    v_max_u32 v180, v180, v67
    v_cmp_eq_u32 vcc, -1, v180
    s_cbranch_vccz L_skip6
    buffer_load_dwordx4 v[64:67], v10, s[40:43], s100 offen sc1
L_skip6:
    s_branch L_poll
L_ready:
    v_dot2c_f32_bf16 v232, s92, v40
    v_dot2c_f32_bf16 v233, s93, v40
    v_dot2c_f32_bf16 v234, s92, v41
    v_dot2c_f32_bf16 v235, s93, v41
    v_dot2c_f32_bf16 v236, s92, v42
    v_dot2c_f32_bf16 v237, s93, v42
    v_dot2c_f32_bf16 v238, s92, v43
    v_dot2c_f32_bf16 v239, s93, v43
    v_dot2c_f32_bf16 v232, s92, v44
    v_dot2c_f32_bf16 v233, s93, v44
    v_dot2c_f32_bf16 v234, s92, v45
    v_dot2c_f32_bf16 v235, s93, v45
    v_dot2c_f32_bf16 v236, s92, v46
    v_dot2c_f32_bf16 v237, s93, v46
    v_dot2c_f32_bf16 v238, s92, v47
    v_dot2c_f32_bf16 v239, s93, v47
    v_dot2c_f32_bf16 v232, s92, v48
    v_dot2c_f32_bf16 v233, s93, v48
    v_dot2c_f32_bf16 v234, s92, v49
    v_dot2c_f32_bf16 v235, s93, v49
    v_dot2c_f32_bf16 v236, s92, v50
    v_dot2c_f32_bf16 v237, s93, v50
    v_dot2c_f32_bf16 v238, s92, v51
    v_dot2c_f32_bf16 v239, s93, v51
    v_dot2c_f32_bf16 v232, s92, v52
    v_dot2c_f32_bf16 v233, s93, v52
    v_dot2c_f32_bf16 v234, s92, v53
    v_dot2c_f32_bf16 v235, s93, v53
    v_dot2c_f32_bf16 v236, s92, v54
    v_dot2c_f32_bf16 v237, s93, v54
    v_dot2c_f32_bf16 v238, s92, v55
    v_dot2c_f32_bf16 v239, s93, v55
    v_dot2c_f32_bf16 v232, s92, v56
    v_dot2c_f32_bf16 v233, s93, v56
    v_dot2c_f32_bf16 v234, s92, v57
    v_dot2c_f32_bf16 v235, s93, v57
    v_dot2c_f32_bf16 v236, s92, v58
    v_dot2c_f32_bf16 v237, s93, v58
    v_dot2c_f32_bf16 v238, s92, v59
    v_dot2c_f32_bf16 v239, s93, v59
    v_dot2c_f32_bf16 v232, s92, v60
    v_dot2c_f32_bf16 v233, s93, v60
    v_dot2c_f32_bf16 v234, s92, v61
    v_dot2c_f32_bf16 v235, s93, v61
    v_dot2c_f32_bf16 v236, s92, v62
    v_dot2c_f32_bf16 v237, s93, v62
    v_dot2c_f32_bf16 v238, s92, v63
    v_dot2c_f32_bf16 v239, s93, v63
    v_dot2c_f32_bf16 v232, s92, v64
    v_dot2c_f32_bf16 v233, s93, v64
    v_dot2c_f32_bf16 v234, s92, v65
    v_dot2c_f32_bf16 v235, s93, v65
    v_dot2c_f32_bf16 v236, s92, v66
    v_dot2c_f32_bf16 v237, s93, v66
    v_dot2c_f32_bf16 v238, s92, v67
    v_dot2c_f32_bf16 v239, s93, v67
    v_cvt_pk_bf16_f32 v176, v232, v233
    v_cvt_pk_bf16_f32 v177, v234, v235
    v_lshlrev_b32 v188, 16, v176
    v_and_b32 v189, 0xffff0000, v176
    v_lshlrev_b32 v190, 16, v177
    v_and_b32 v191, 0xffff0000, v177
    ds_write_b64 v9, v[176:177]
    v_sub_f32 v188, v232, v188
    v_sub_f32 v189, v233, v189
    v_sub_f32 v190, v234, v190
    v_sub_f32 v191, v235, v191
    v_cvt_pk_bf16_f32 v178, v188, v189
    v_cvt_pk_bf16_f32 v179, v190, v191
    ds_write_b64 v9, v[178:179] offset:256
    v_cvt_pk_bf16_f32 v180, v236, v237
    v_cvt_pk_bf16_f32 v181, v238, v239
    v_lshlrev_b32 v192, 16, v180
    v_and_b32 v193, 0xffff0000, v180
    v_lshlrev_b32 v194, 16, v181
    v_and_b32 v195, 0xffff0000, v181
    ds_write_b64 v11, v[180:181]
    v_sub_f32 v192, v236, v192
    v_sub_f32 v193, v237, v193
    v_sub_f32 v194, v238, v194
    v_sub_f32 v195, v239, v195
    v_cvt_pk_bf16_f32 v182, v192, v193
    v_cvt_pk_bf16_f32 v183, v194, v195
    ds_write_b64 v11, v[182:183] offset:256
    s_setprio 0
    s_mov_b32 exec_hi, -1
L_join0:
    s_waitcnt lgkmcnt(0)
    s_barrier
    v_lshlrev_b32 v9, 3, v1
    v_add_u32 v9, 151552, v9
    ds_read_b64 v[64:65], v9 offset:6144
    ds_read_b64 v[40:41], v9 offset:0
    ds_read_b64 v[42:43], v9 offset:512
    ds_read_b64 v[44:45], v9 offset:1024
    ds_read_b64 v[46:47], v9 offset:1536
    ds_read_b64 v[48:49], v9 offset:2048
    ds_read_b64 v[50:51], v9 offset:2560
    ds_read_b64 v[52:53], v9 offset:3072
    ds_read_b64 v[54:55], v9 offset:3584
    ds_read_b64 v[56:57], v9 offset:4096
    ds_read_b64 v[58:59], v9 offset:4608
    ds_read_b64 v[60:61], v9 offset:5120
    ds_read_b64 v[62:63], v9 offset:5632
    s_waitcnt lgkmcnt(12)
    v_mfma_f32_16x16x16_bf16 v[208:211], v[152:153], v[64:65], 0
    s_waitcnt lgkmcnt(8)
    v_mfma_f32_16x16x16_bf16 v[160:163], v[152:153], v[40:41], 0
    v_mfma_f32_16x16x16_bf16 v[164:167], v[152:153], v[42:43], 0
    v_mfma_f32_16x16x16_bf16 v[168:171], v[152:153], v[44:45], 0
    v_mfma_f32_16x16x16_bf16 v[172:175], v[152:153], v[46:47], 0
    s_nop 2
    v_add_f32 v136, v208, v13
    v_add_f32 v137, v209, v13
    v_add_f32 v138, v210, v13
    v_add_f32 v139, v211, v13
    s_waitcnt lgkmcnt(4)
    v_mfma_f32_16x16x16_bf16 v[176:179], v[152:153], v[48:49], 0
    v_mfma_f32_16x16x16_bf16 v[180:183], v[152:153], v[50:51], 0
    v_rcp_f32 v136, v136
    v_rcp_f32 v137, v137
    v_rcp_f32 v138, v138
    v_rcp_f32 v139, v139
    v_mfma_f32_16x16x16_bf16 v[184:187], v[152:153], v[52:53], 0
    v_mfma_f32_16x16x16_bf16 v[188:191], v[152:153], v[54:55], 0
    s_waitcnt lgkmcnt(0)
    v_mfma_f32_16x16x16_bf16 v[192:195], v[152:153], v[56:57], 0
    v_mfma_f32_16x16x16_bf16 v[196:199], v[152:153], v[58:59], 0
    v_mfma_f32_16x16x16_bf16 v[200:203], v[152:153], v[60:61], 0
    v_mfma_f32_16x16x16_bf16 v[204:207], v[152:153], v[62:63], 0
    v_pk_mul_f32 v[160:161], v[160:161], v[136:137]
    v_pk_mul_f32 v[164:165], v[164:165], v[136:137]
    v_pk_mul_f32 v[168:169], v[168:169], v[136:137]
    v_pk_mul_f32 v[172:173], v[172:173], v[136:137]
    v_pk_mul_f32 v[176:177], v[176:177], v[136:137]
    v_pk_mul_f32 v[180:181], v[180:181], v[136:137]
    v_pk_mul_f32 v[184:185], v[184:185], v[136:137]
    v_pk_mul_f32 v[188:189], v[188:189], v[136:137]
    v_pk_mul_f32 v[192:193], v[192:193], v[136:137]
    v_pk_mul_f32 v[196:197], v[196:197], v[136:137]
    v_pk_mul_f32 v[200:201], v[200:201], v[136:137]
    v_pk_mul_f32 v[204:205], v[204:205], v[136:137]
    v_cvt_pk_bf16_f32 v88, v160, v164
    v_cvt_pk_bf16_f32 v89, v168, v172
    v_cvt_pk_bf16_f32 v90, v176, v180
    v_cvt_pk_bf16_f32 v91, v184, v188
    buffer_store_dwordx4 v[88:91], v5, s[36:39], s19 offen offset:0 sc1
    v_cvt_pk_bf16_f32 v92, v192, v196
    v_cvt_pk_bf16_f32 v93, v200, v204
    buffer_store_dwordx2 v[92:93], v6, s[36:39], s19 offen offset:0 sc1
    v_cvt_pk_bf16_f32 v94, v161, v165
    v_cvt_pk_bf16_f32 v95, v169, v173
    v_cvt_pk_bf16_f32 v96, v177, v181
    v_cvt_pk_bf16_f32 v97, v185, v189
    buffer_store_dwordx4 v[94:97], v5, s[36:39], s19 offen offset:384 sc1
    v_cvt_pk_bf16_f32 v98, v193, v197
    v_cvt_pk_bf16_f32 v99, v201, v205
    buffer_store_dwordx2 v[98:99], v6, s[36:39], s19 offen offset:384 sc1
    v_pk_mul_f32 v[162:163], v[162:163], v[138:139]
    v_pk_mul_f32 v[166:167], v[166:167], v[138:139]
    v_pk_mul_f32 v[170:171], v[170:171], v[138:139]
    v_pk_mul_f32 v[174:175], v[174:175], v[138:139]
    v_pk_mul_f32 v[178:179], v[178:179], v[138:139]
    v_pk_mul_f32 v[182:183], v[182:183], v[138:139]
    v_pk_mul_f32 v[186:187], v[186:187], v[138:139]
    v_pk_mul_f32 v[190:191], v[190:191], v[138:139]
    v_pk_mul_f32 v[194:195], v[194:195], v[138:139]
    v_pk_mul_f32 v[198:199], v[198:199], v[138:139]
    v_pk_mul_f32 v[202:203], v[202:203], v[138:139]
    v_pk_mul_f32 v[206:207], v[206:207], v[138:139]
    v_cvt_pk_bf16_f32 v100, v162, v166
    v_cvt_pk_bf16_f32 v101, v170, v174
    v_cvt_pk_bf16_f32 v102, v178, v182
    v_cvt_pk_bf16_f32 v103, v186, v190
    buffer_store_dwordx4 v[100:103], v5, s[36:39], s19 offen offset:768 sc1
    v_cvt_pk_bf16_f32 v104, v194, v198
    v_cvt_pk_bf16_f32 v105, v202, v206
    buffer_store_dwordx2 v[104:105], v6, s[36:39], s19 offen offset:768 sc1
    v_cvt_pk_bf16_f32 v106, v163, v167
    v_cvt_pk_bf16_f32 v107, v171, v175
    v_cvt_pk_bf16_f32 v108, v179, v183
    v_cvt_pk_bf16_f32 v109, v187, v191
    buffer_store_dwordx4 v[106:109], v5, s[36:39], s19 offen offset:1152 sc1
    v_cvt_pk_bf16_f32 v110, v195, v199
    v_cvt_pk_bf16_f32 v111, v203, v207
    buffer_store_dwordx2 v[110:111], v6, s[36:39], s19 offen offset:1152 sc1
    v_mfma_f32_16x16x16_bf16 v[208:211], v[154:155], v[64:65], 0
    v_mfma_f32_16x16x16_bf16 v[160:163], v[154:155], v[40:41], 0
    v_mfma_f32_16x16x16_bf16 v[164:167], v[154:155], v[42:43], 0
    v_mfma_f32_16x16x16_bf16 v[168:171], v[154:155], v[44:45], 0
    v_mfma_f32_16x16x16_bf16 v[172:175], v[154:155], v[46:47], 0
    s_nop 3
    v_add_f32 v136, v208, v13
    v_add_f32 v137, v209, v13
    v_add_f32 v138, v210, v13
    v_add_f32 v139, v211, v13
    v_mfma_f32_16x16x16_bf16 v[176:179], v[154:155], v[48:49], 0
    v_mfma_f32_16x16x16_bf16 v[180:183], v[154:155], v[50:51], 0
    v_rcp_f32 v136, v136
    v_rcp_f32 v137, v137
    v_rcp_f32 v138, v138
    v_rcp_f32 v139, v139
    v_mfma_f32_16x16x16_bf16 v[184:187], v[154:155], v[52:53], 0
    v_mfma_f32_16x16x16_bf16 v[188:191], v[154:155], v[54:55], 0
    v_mfma_f32_16x16x16_bf16 v[192:195], v[154:155], v[56:57], 0
    v_mfma_f32_16x16x16_bf16 v[196:199], v[154:155], v[58:59], 0
    v_mfma_f32_16x16x16_bf16 v[200:203], v[154:155], v[60:61], 0
    v_mfma_f32_16x16x16_bf16 v[204:207], v[154:155], v[62:63], 0
    v_pk_mul_f32 v[160:161], v[160:161], v[136:137]
    v_pk_mul_f32 v[164:165], v[164:165], v[136:137]
    v_pk_mul_f32 v[168:169], v[168:169], v[136:137]
    v_pk_mul_f32 v[172:173], v[172:173], v[136:137]
    v_pk_mul_f32 v[176:177], v[176:177], v[136:137]
    v_pk_mul_f32 v[180:181], v[180:181], v[136:137]
    v_pk_mul_f32 v[184:185], v[184:185], v[136:137]
    v_pk_mul_f32 v[188:189], v[188:189], v[136:137]
    v_pk_mul_f32 v[192:193], v[192:193], v[136:137]
    v_pk_mul_f32 v[196:197], v[196:197], v[136:137]
    v_pk_mul_f32 v[200:201], v[200:201], v[136:137]
    v_pk_mul_f32 v[204:205], v[204:205], v[136:137]
    v_cvt_pk_bf16_f32 v112, v160, v164
    v_cvt_pk_bf16_f32 v113, v168, v172
    v_cvt_pk_bf16_f32 v114, v176, v180
    v_cvt_pk_bf16_f32 v115, v184, v188
    buffer_store_dwordx4 v[112:115], v5, s[36:39], s49 offen offset:0 sc1
    v_cvt_pk_bf16_f32 v116, v192, v196
    v_cvt_pk_bf16_f32 v117, v200, v204
    buffer_store_dwordx2 v[116:117], v6, s[36:39], s49 offen offset:0 sc1
    v_cvt_pk_bf16_f32 v118, v161, v165
    v_cvt_pk_bf16_f32 v119, v169, v173
    v_cvt_pk_bf16_f32 v120, v177, v181
    v_cvt_pk_bf16_f32 v121, v185, v189
    buffer_store_dwordx4 v[118:121], v5, s[36:39], s49 offen offset:384 sc1
    v_cvt_pk_bf16_f32 v122, v193, v197
    v_cvt_pk_bf16_f32 v123, v201, v205
    buffer_store_dwordx2 v[122:123], v6, s[36:39], s49 offen offset:384 sc1
    v_pk_mul_f32 v[162:163], v[162:163], v[138:139]
    v_pk_mul_f32 v[166:167], v[166:167], v[138:139]
    v_pk_mul_f32 v[170:171], v[170:171], v[138:139]
    v_pk_mul_f32 v[174:175], v[174:175], v[138:139]
    v_pk_mul_f32 v[178:179], v[178:179], v[138:139]
    v_pk_mul_f32 v[182:183], v[182:183], v[138:139]
    v_pk_mul_f32 v[186:187], v[186:187], v[138:139]
    v_pk_mul_f32 v[190:191], v[190:191], v[138:139]
    v_pk_mul_f32 v[194:195], v[194:195], v[138:139]
    v_pk_mul_f32 v[198:199], v[198:199], v[138:139]
    v_pk_mul_f32 v[202:203], v[202:203], v[138:139]
    v_pk_mul_f32 v[206:207], v[206:207], v[138:139]
    v_cvt_pk_bf16_f32 v124, v162, v166
    v_cvt_pk_bf16_f32 v125, v170, v174
    v_cvt_pk_bf16_f32 v126, v178, v182
    v_cvt_pk_bf16_f32 v127, v186, v190
    buffer_store_dwordx4 v[124:127], v5, s[36:39], s49 offen offset:768 sc1
    v_cvt_pk_bf16_f32 v128, v194, v198
    v_cvt_pk_bf16_f32 v129, v202, v206
    buffer_store_dwordx2 v[128:129], v6, s[36:39], s49 offen offset:768 sc1
    v_cvt_pk_bf16_f32 v130, v163, v167
    v_cvt_pk_bf16_f32 v131, v171, v175
    v_cvt_pk_bf16_f32 v132, v179, v183
    v_cvt_pk_bf16_f32 v133, v187, v191
    buffer_store_dwordx4 v[130:133], v5, s[36:39], s49 offen offset:1152 sc1
    v_cvt_pk_bf16_f32 v134, v195, v199
    v_cvt_pk_bf16_f32 v135, v203, v207
    buffer_store_dwordx2 v[134:135], v6, s[36:39], s49 offen offset:1152 sc1
    s_endpgm
L_hi1:
    s_waitcnt lgkmcnt(0)
    s_barrier
    s_add_u32 m0, s48, 0
    s_nop 0
    buffer_load_dwordx4 v2, s[20:23], s19 offen offset:0 nt lds
    s_add_u32 m0, s48, 896
    s_nop 0
    buffer_load_dwordx4 v2, s[20:23], s19 offen offset:128 nt lds
    s_add_u32 m0, s48, 1792
    s_nop 0
    buffer_load_dwordx4 v2, s[20:23], s19 offen offset:256 nt lds
    s_add_u32 m0, s48, 0
    s_nop 0
    buffer_load_dwordx4 v3, s[20:23], s19 offen offset:3072 nt lds
    s_add_u32 m0, s48, 896
    s_nop 0
    buffer_load_dwordx4 v3, s[20:23], s19 offen offset:3200 nt lds
    s_add_u32 m0, s48, 1792
    s_nop 0
    buffer_load_dwordx4 v3, s[20:23], s19 offen offset:3328 nt lds
    s_add_u32 m0, s48, 6144
    s_nop 0
    buffer_load_dwordx4 v2, s[20:23], s49 offen offset:0 nt lds
    s_add_u32 m0, s48, 7040
    s_nop 0
    buffer_load_dwordx4 v2, s[20:23], s49 offen offset:128 nt lds
    s_add_u32 m0, s48, 7936
    s_nop 0
    buffer_load_dwordx4 v2, s[20:23], s49 offen offset:256 nt lds
    s_add_u32 m0, s48, 6144
    s_nop 0
    buffer_load_dwordx4 v3, s[20:23], s49 offen offset:3072 nt lds
    s_add_u32 m0, s48, 7040
    s_nop 0
    buffer_load_dwordx4 v3, s[20:23], s49 offen offset:3200 nt lds
    s_add_u32 m0, s48, 7936
    s_nop 0
    buffer_load_dwordx4 v3, s[20:23], s49 offen offset:3328 nt lds
    s_cmp_lg_u32 s18, 7
    s_cbranch_scc1 L_notrig
    s_waitcnt vmcnt(2)
    v_mov_b32 v9, 158208
    v_mov_b32 v10, 1
    ds_write_b32 v9, v10
L_notrig:
    s_waitcnt vmcnt(0) lgkmcnt(0)
    s_branch L_feat
L_end_standalone__linear_kernel_rfa__prompt_kernel:
    s_endpgm
.section .rodata,"a"
.p2align 6
.amdhsa_kernel standalone__linear_kernel_rfa__prompt_kernel
  .amdhsa_next_free_vgpr 240
  .amdhsa_next_free_sgpr 102
  .amdhsa_accum_offset 240
  .amdhsa_group_segment_fixed_size 0
  .amdhsa_kernarg_size 56
  .amdhsa_user_sgpr_count 2
  .amdhsa_user_sgpr_kernarg_segment_ptr 1
  .amdhsa_system_sgpr_workgroup_id_x 1
.end_amdhsa_kernel
.text
```
